```python
import torch

def _softmax(x, axis=-1):
    return torch.softmax(x, dim=axis)
def _gelu(x):
    return torch.nn.functional.gelu(x, approximate="tanh")
def _silu(x):
    return torch.nn.functional.silu(x)
def _sigmoid(x):
    return torch.sigmoid(x)
def _layernorm(x, axis=-1, eps=1e-5):
    m = x.mean(dim=axis, keepdim=True)
    v = x.var(dim=axis, keepdim=True, unbiased=False)
    return (x - m) / torch.sqrt(v + eps)
def _scatter_add(tgt, idx, src, axis=0):
    return tgt.clone().index_add_(axis, idx, src)
def _segment_sum(src, seg, n):
    out = torch.zeros((n,) + src.shape[1:], dtype=src.dtype)
    return out.index_add_(0, seg, src)
def _pad(x, pw):
    flat = tuple(v for pair in reversed(pw) for v in pair)
    return torch.nn.functional.pad(x, flat)

kernel_name = 'standalone__softmax_full_bidir__decode'

def setup_inputs():

    _w = (lambda a: (lambda t: t.to(torch.bfloat16) if t.is_floating_point() else t)(torch.as_tensor(a)))
    B, H, Sq, Skv, Dh = 1, 32, 1, 4096, 128
    return {
        "q": _w((lambda *s: torch.randn(*s, dtype=torch.bfloat16) * 0.8)(B, H, Sq, Dh)),
        "k": _w((lambda *s: torch.randn(*s, dtype=torch.bfloat16) * 0.8)(B, H, Skv, Dh)),
        "v": _w((lambda *s: torch.randn(*s, dtype=torch.bfloat16) * 0.05)(B, H, Skv, Dh)),
    }

def reference(q, k, v):
    scale = q.shape[-1] ** -0.5
    scores = torch.einsum('bhqd,bhkd->bhqk', q, k) * scale
    attn = _softmax(scores, axis=-1)
    return torch.einsum('bhqk,bhkd->bhqd', attn, v)
```

```asm
; @launch grid=(256,1,1) block=(512,1,1) lds=4416
.amdgcn_target "amdgcn-amd-amdhsa--gfx950"
.text
.globl standalone__softmax_full_bidir__decode_kernel
.p2align 8
.type standalone__softmax_full_bidir__decode_kernel,@function
standalone__softmax_full_bidir__decode_kernel:
    s_load_dwordx2 s[16:17], s[0:1], 8
    v_readfirstlane_b32 s42, v0
    s_and_b32 s40, s2, 7
    s_lshr_b32 s41, s2, 3
    s_lshl_b32 s44, s40, 5
    s_or_b32 s41, s44, s41
    s_lshl_b32 s44, s41, 9
    s_or_b32 s44, s44, s42
    s_lshl_b32 s44, s44, 8
    v_and_b32 v2, 63, v0
    v_lshlrev_b32 v1, 4, v2
    s_brev_b32 s18, 64
    s_mov_b32 s19, 0x20000
    s_cmpk_ge_u32 s2, 256
    s_cbranch_scc1 L_end
    s_cmpk_lg_u32 s42, 448
    s_cbranch_scc1 L_nopf
    s_getpc_b64 s[6:7]
L_pc:
    v_lshlrev_b32 v4, 7, v2
    v_min_u32 v4, L_codeend-L_pc-4, v4
    v_mov_b32 v5, s7
    v_add_co_u32 v4, vcc, s6, v4
    s_nop 1
    v_addc_co_u32 v5, vcc, 0, v5, vcc
    global_load_dword v222, v[4:5], off
L_nopf:
    s_waitcnt lgkmcnt(0)
    buffer_load_dwordx4 v[44:47], v1, s[16:19], s44 offen offset:0 nt
    buffer_load_dwordx4 v[48:51], v1, s[16:19], s44 offen offset:1024 nt
    buffer_load_dwordx4 v[52:55], v1, s[16:19], s44 offen offset:2048 nt
    buffer_load_dwordx4 v[56:59], v1, s[16:19], s44 offen offset:3072 nt
    s_addk_i32 s44, 0x1000
    buffer_load_dwordx4 v[60:63], v1, s[16:19], s44 offen offset:0 nt
    buffer_load_dwordx4 v[64:67], v1, s[16:19], s44 offen offset:1024 nt
    buffer_load_dwordx4 v[68:71], v1, s[16:19], s44 offen offset:2048 nt
    buffer_load_dwordx4 v[72:75], v1, s[16:19], s44 offen offset:3072 nt
    s_addk_i32 s44, 0x1000
    buffer_load_dwordx4 v[76:79], v1, s[16:19], s44 offen offset:0 nt
    buffer_load_dwordx4 v[80:83], v1, s[16:19], s44 offen offset:1024 nt
    buffer_load_dwordx4 v[84:87], v1, s[16:19], s44 offen offset:2048 nt
    buffer_load_dwordx4 v[88:91], v1, s[16:19], s44 offen offset:3072 nt
    s_addk_i32 s44, 0x1000
    buffer_load_dwordx4 v[92:95], v1, s[16:19], s44 offen offset:0 nt
    buffer_load_dwordx4 v[96:99], v1, s[16:19], s44 offen offset:1024 nt
    buffer_load_dwordx4 v[100:103], v1, s[16:19], s44 offen offset:2048 nt
    buffer_load_dwordx4 v[104:107], v1, s[16:19], s44 offen offset:3072 nt
    s_load_dwordx2 s[24:25], s[0:1], 0
    s_load_dwordx2 s[20:21], s[0:1], 16
    s_load_dwordx2 s[28:29], s[0:1], 40
    s_load_dwordx2 s[36:37], s[0:1], 24
    s_mov_b32 s47, s44
    s_sub_u32 s46, s44, 0x1000
    s_sub_u32 s45, s44, 0x2000
    s_sub_u32 s44, s44, 0x3000
    s_lshr_b32 s40, s41, 3
    s_and_b32 s41, s41, 7
    s_lshr_b32 s42, s42, 6
    s_mov_b32 s26, 0x2000
    s_mov_b32 s27, 0x20000
    v_and_b32 v3, 0xf0, v1
    s_lshl_b32 s3, s40, 8
    s_lshl_b32 s5, s40, 7
    s_waitcnt lgkmcnt(0)
    buffer_load_dwordx4 v[28:31], v3, s[24:27], s3 offen
    s_load_dword s43, s[28:29], s5
    s_mov_b32 s22, 0x2000000
    s_mov_b32 s23, 0x20000
    s_mov_b32 s38, 0x2000
    s_mov_b32 s39, 0x20000
    s_mov_b32 s30, 532480
    s_mov_b32 s31, 0x20000
    v_and_b32 v4, 15, v0
    v_and_b32 v5, 1, v0
    v_lshlrev_b32 v5, 4, v5
    v_mov_b32 v8, 0xffff
    v_lshlrev_b32 v5, v5, v8
    v_lshrrev_b32 v8, 1, v4
    v_cmp_eq_u32 vcc, 0, v8
    s_nop 1
    v_cndmask_b32 v32, 0, v5, vcc
    v_cmp_eq_u32 vcc, 1, v8
    s_nop 1
    v_cndmask_b32 v33, 0, v5, vcc
    v_cmp_eq_u32 vcc, 2, v8
    s_nop 1
    v_cndmask_b32 v34, 0, v5, vcc
    v_cmp_eq_u32 vcc, 3, v8
    s_nop 1
    v_cndmask_b32 v35, 0, v5, vcc
    s_mov_b32 s4, 0x3e0293ee
    s_mul_i32 s6, s42, 544
    v_lshlrev_b32 v6, 5, v4
    v_and_b32 v8, 16, v0
    v_add3_u32 v6, v6, v8, s6
    v_lshlrev_b32 v7, 3, v2
    v_lshlrev_b32 v9, 2, v2
    v_mov_b32 v10, 4352
    v_and_b32 v8, 7, v0
    v_and_b32 v225, 0x38, v0
    s_lshl_b32 s6, s42, 6
    v_add_u32 v225, s6, v225
    v_lshlrev_b32 v224, 1, v225
    v_lshl_add_u32 v224, v8, 10, v224
    v_mul_u32_u24 v8, 544, v8
    v_add_u32 v225, v225, v8
    v_lshrrev_b32 v226, 1, v2
    v_lshlrev_b32 v227, 7, v2
    s_lshl_b32 s54, s42, 5
    s_add_u32 s54, s54, s3
    v_mov_b32 v8, 0
    s_lshl_b32 s6, s40, 13
    s_add_u32 s48, s6, 4096
    s_add_u32 s49, s6, 266240
    s_lshl_b32 s7, s41, 10
    s_add_u32 s50, s48, s7
    s_add_u32 s51, s49, s7
    s_lshl_b32 s7, s41, 4
    s_add_u32 s55, s49, s7
    s_lshl_b32 s7, s42, 10
    s_add_u32 s53, s49, s7
    s_lshl_b32 s7, s42, 7
    s_add_u32 s7, s7, s51
    v_and_b32 v220, 0x7c, v9
    buffer_load_dword v221, v220, s[28:31], s7 offen
    s_getreg_b32 s56, hwreg(HW_REG_XCC_ID)
    s_add_u32 s60, s5, 528384
    s_mov_b64 s[58:59], 0
    s_lshl_b32 s6, s41, 3
    s_or_b32 s6, s6, s42
    s_cmp_lg_u32 s6, 0
    s_cbranch_scc1 L_nohello
    s_waitcnt lgkmcnt(0)
    s_mul_i32 s57, s43, 0x9E3779B1
    s_add_u32 s57, s57, 0x7F4A7C15
    v_mov_b32 v174, s56
    v_mov_b32 v175, s57
    buffer_store_dwordx2 v[174:175], v8, s[28:31], s60 offen
L_nohello:
    s_cmp_lt_u32 s42, 4
    s_cbranch_scc1 L_late1
    s_barrier
    s_setprio 3
    buffer_load_dwordx4 v[108:111], v1, s[20:23], s44 offen offset:0 nt
    buffer_load_dwordx4 v[112:115], v1, s[20:23], s44 offen offset:1024 nt
    buffer_load_dwordx4 v[116:119], v1, s[20:23], s44 offen offset:2048 nt
    buffer_load_dwordx4 v[120:123], v1, s[20:23], s44 offen offset:3072 nt
    buffer_load_dwordx4 v[124:127], v1, s[20:23], s45 offen offset:0 nt
    buffer_load_dwordx4 v[128:131], v1, s[20:23], s45 offen offset:1024 nt
    buffer_load_dwordx4 v[132:135], v1, s[20:23], s45 offen offset:2048 nt
    buffer_load_dwordx4 v[136:139], v1, s[20:23], s45 offen offset:3072 nt
    buffer_load_dwordx4 v[140:143], v1, s[20:23], s46 offen offset:0 nt
    buffer_load_dwordx4 v[144:147], v1, s[20:23], s46 offen offset:1024 nt
    buffer_load_dwordx4 v[148:151], v1, s[20:23], s46 offen offset:2048 nt
    buffer_load_dwordx4 v[152:155], v1, s[20:23], s46 offen offset:3072 nt
    buffer_load_dwordx4 v[156:159], v1, s[20:23], s47 offen offset:0 nt
    buffer_load_dwordx4 v[160:163], v1, s[20:23], s47 offen offset:1024 nt
    buffer_load_dwordx4 v[164:167], v1, s[20:23], s47 offen offset:2048 nt
    buffer_load_dwordx4 v[168:171], v1, s[20:23], s47 offen offset:3072 nt
    s_setprio 0
    s_waitcnt vmcnt(16)
    s_branch L_qk
L_late1:
    s_waitcnt vmcnt(0)
L_qk:
    v_dot2_f32_bf16 v12, v44, v28, 0
    v_dot2_f32_bf16 v13, v48, v28, 0
    v_dot2_f32_bf16 v14, v52, v28, 0
    v_dot2_f32_bf16 v15, v56, v28, 0
    v_dot2_f32_bf16 v16, v60, v28, 0
    v_dot2_f32_bf16 v17, v64, v28, 0
    v_dot2_f32_bf16 v18, v68, v28, 0
    v_dot2_f32_bf16 v19, v72, v28, 0
    v_dot2_f32_bf16 v20, v76, v28, 0
    v_dot2_f32_bf16 v21, v80, v28, 0
    v_dot2_f32_bf16 v22, v84, v28, 0
    v_dot2_f32_bf16 v23, v88, v28, 0
    v_dot2_f32_bf16 v24, v92, v28, 0
    v_dot2_f32_bf16 v25, v96, v28, 0
    v_dot2_f32_bf16 v26, v100, v28, 0
    v_dot2_f32_bf16 v27, v104, v28, 0
    v_dot2c_f32_bf16 v12, v45, v29
    v_dot2c_f32_bf16 v13, v49, v29
    v_dot2c_f32_bf16 v14, v53, v29
    v_dot2c_f32_bf16 v15, v57, v29
    v_dot2c_f32_bf16 v16, v61, v29
    v_dot2c_f32_bf16 v17, v65, v29
    v_dot2c_f32_bf16 v18, v69, v29
    v_dot2c_f32_bf16 v19, v73, v29
    v_dot2c_f32_bf16 v20, v77, v29
    v_dot2c_f32_bf16 v21, v81, v29
    v_dot2c_f32_bf16 v22, v85, v29
    v_dot2c_f32_bf16 v23, v89, v29
    v_dot2c_f32_bf16 v24, v93, v29
    v_dot2c_f32_bf16 v25, v97, v29
    v_dot2c_f32_bf16 v26, v101, v29
    v_dot2c_f32_bf16 v27, v105, v29
    v_dot2c_f32_bf16 v12, v46, v30
    v_dot2c_f32_bf16 v13, v50, v30
    v_dot2c_f32_bf16 v14, v54, v30
    v_dot2c_f32_bf16 v15, v58, v30
    v_dot2c_f32_bf16 v16, v62, v30
    v_dot2c_f32_bf16 v17, v66, v30
    v_dot2c_f32_bf16 v18, v70, v30
    v_dot2c_f32_bf16 v19, v74, v30
    v_dot2c_f32_bf16 v20, v78, v30
    v_dot2c_f32_bf16 v21, v82, v30
    v_dot2c_f32_bf16 v22, v86, v30
    v_dot2c_f32_bf16 v23, v90, v30
    v_dot2c_f32_bf16 v24, v94, v30
    v_dot2c_f32_bf16 v25, v98, v30
    v_dot2c_f32_bf16 v26, v102, v30
    v_dot2c_f32_bf16 v27, v106, v30
    v_dot2c_f32_bf16 v12, v47, v31
    v_dot2c_f32_bf16 v13, v51, v31
    v_dot2c_f32_bf16 v14, v55, v31
    v_dot2c_f32_bf16 v15, v59, v31
    v_dot2c_f32_bf16 v16, v63, v31
    v_dot2c_f32_bf16 v17, v67, v31
    v_dot2c_f32_bf16 v18, v71, v31
    v_dot2c_f32_bf16 v19, v75, v31
    v_dot2c_f32_bf16 v20, v79, v31
    v_dot2c_f32_bf16 v21, v83, v31
    v_dot2c_f32_bf16 v22, v87, v31
    v_dot2c_f32_bf16 v23, v91, v31
    v_dot2c_f32_bf16 v24, v95, v31
    v_dot2c_f32_bf16 v25, v99, v31
    v_dot2c_f32_bf16 v26, v103, v31
    v_dot2c_f32_bf16 v27, v107, v31
    v_add_f32_dpp v12, v12, v12 row_ror:8 row_mask:0xf bank_mask:0xf
    v_add_f32_dpp v13, v13, v13 row_ror:8 row_mask:0xf bank_mask:0xf
    v_add_f32_dpp v14, v14, v14 row_ror:8 row_mask:0xf bank_mask:0xf
    v_add_f32_dpp v15, v15, v15 row_ror:8 row_mask:0xf bank_mask:0xf
    v_add_f32_dpp v16, v16, v16 row_ror:8 row_mask:0xf bank_mask:0xf
    v_add_f32_dpp v17, v17, v17 row_ror:8 row_mask:0xf bank_mask:0xf
    v_add_f32_dpp v18, v18, v18 row_ror:8 row_mask:0xf bank_mask:0xf
    v_add_f32_dpp v19, v19, v19 row_ror:8 row_mask:0xf bank_mask:0xf
    v_add_f32_dpp v20, v20, v20 row_ror:8 row_mask:0xf bank_mask:0xf
    v_add_f32_dpp v21, v21, v21 row_ror:8 row_mask:0xf bank_mask:0xf
    v_add_f32_dpp v22, v22, v22 row_ror:8 row_mask:0xf bank_mask:0xf
    v_add_f32_dpp v23, v23, v23 row_ror:8 row_mask:0xf bank_mask:0xf
    v_add_f32_dpp v24, v24, v24 row_ror:8 row_mask:0xf bank_mask:0xf
    v_add_f32_dpp v25, v25, v25 row_ror:8 row_mask:0xf bank_mask:0xf
    v_add_f32_dpp v26, v26, v26 row_ror:8 row_mask:0xf bank_mask:0xf
    v_add_f32_dpp v27, v27, v27 row_ror:8 row_mask:0xf bank_mask:0xf
    v_add_f32_dpp v12, v12, v12 row_ror:4 row_mask:0xf bank_mask:0xf
    v_add_f32_dpp v13, v13, v13 row_ror:4 row_mask:0xf bank_mask:0xf
    v_add_f32_dpp v14, v14, v14 row_ror:4 row_mask:0xf bank_mask:0xf
    v_add_f32_dpp v15, v15, v15 row_ror:4 row_mask:0xf bank_mask:0xf
    v_add_f32_dpp v16, v16, v16 row_ror:4 row_mask:0xf bank_mask:0xf
    v_add_f32_dpp v17, v17, v17 row_ror:4 row_mask:0xf bank_mask:0xf
    v_add_f32_dpp v18, v18, v18 row_ror:4 row_mask:0xf bank_mask:0xf
    v_add_f32_dpp v19, v19, v19 row_ror:4 row_mask:0xf bank_mask:0xf
    v_add_f32_dpp v20, v20, v20 row_ror:4 row_mask:0xf bank_mask:0xf
    v_add_f32_dpp v21, v21, v21 row_ror:4 row_mask:0xf bank_mask:0xf
    v_add_f32_dpp v22, v22, v22 row_ror:4 row_mask:0xf bank_mask:0xf
    v_add_f32_dpp v23, v23, v23 row_ror:4 row_mask:0xf bank_mask:0xf
    v_add_f32_dpp v24, v24, v24 row_ror:4 row_mask:0xf bank_mask:0xf
    v_add_f32_dpp v25, v25, v25 row_ror:4 row_mask:0xf bank_mask:0xf
    v_add_f32_dpp v26, v26, v26 row_ror:4 row_mask:0xf bank_mask:0xf
    v_add_f32_dpp v27, v27, v27 row_ror:4 row_mask:0xf bank_mask:0xf
    v_add_f32_dpp v12, v12, v12 row_ror:2 row_mask:0xf bank_mask:0xf
    v_add_f32_dpp v13, v13, v13 row_ror:2 row_mask:0xf bank_mask:0xf
    v_add_f32_dpp v14, v14, v14 row_ror:2 row_mask:0xf bank_mask:0xf
    v_add_f32_dpp v15, v15, v15 row_ror:2 row_mask:0xf bank_mask:0xf
    v_add_f32_dpp v16, v16, v16 row_ror:2 row_mask:0xf bank_mask:0xf
    v_add_f32_dpp v17, v17, v17 row_ror:2 row_mask:0xf bank_mask:0xf
    v_add_f32_dpp v18, v18, v18 row_ror:2 row_mask:0xf bank_mask:0xf
    v_add_f32_dpp v19, v19, v19 row_ror:2 row_mask:0xf bank_mask:0xf
    v_add_f32_dpp v20, v20, v20 row_ror:2 row_mask:0xf bank_mask:0xf
    v_add_f32_dpp v21, v21, v21 row_ror:2 row_mask:0xf bank_mask:0xf
    v_add_f32_dpp v22, v22, v22 row_ror:2 row_mask:0xf bank_mask:0xf
    v_add_f32_dpp v23, v23, v23 row_ror:2 row_mask:0xf bank_mask:0xf
    v_add_f32_dpp v24, v24, v24 row_ror:2 row_mask:0xf bank_mask:0xf
    v_add_f32_dpp v25, v25, v25 row_ror:2 row_mask:0xf bank_mask:0xf
    v_add_f32_dpp v26, v26, v26 row_ror:2 row_mask:0xf bank_mask:0xf
    v_add_f32_dpp v27, v27, v27 row_ror:2 row_mask:0xf bank_mask:0xf
    v_add_f32_dpp v12, v12, v12 row_ror:1 row_mask:0xf bank_mask:0xf
    v_add_f32_dpp v13, v13, v13 row_ror:1 row_mask:0xf bank_mask:0xf
    v_add_f32_dpp v14, v14, v14 row_ror:1 row_mask:0xf bank_mask:0xf
    v_add_f32_dpp v15, v15, v15 row_ror:1 row_mask:0xf bank_mask:0xf
    v_add_f32_dpp v16, v16, v16 row_ror:1 row_mask:0xf bank_mask:0xf
    v_add_f32_dpp v17, v17, v17 row_ror:1 row_mask:0xf bank_mask:0xf
    v_add_f32_dpp v18, v18, v18 row_ror:1 row_mask:0xf bank_mask:0xf
    v_add_f32_dpp v19, v19, v19 row_ror:1 row_mask:0xf bank_mask:0xf
    v_add_f32_dpp v20, v20, v20 row_ror:1 row_mask:0xf bank_mask:0xf
    v_add_f32_dpp v21, v21, v21 row_ror:1 row_mask:0xf bank_mask:0xf
    v_add_f32_dpp v22, v22, v22 row_ror:1 row_mask:0xf bank_mask:0xf
    v_add_f32_dpp v23, v23, v23 row_ror:1 row_mask:0xf bank_mask:0xf
    v_add_f32_dpp v24, v24, v24 row_ror:1 row_mask:0xf bank_mask:0xf
    v_add_f32_dpp v25, v25, v25 row_ror:1 row_mask:0xf bank_mask:0xf
    v_add_f32_dpp v26, v26, v26 row_ror:1 row_mask:0xf bank_mask:0xf
    v_add_f32_dpp v27, v27, v27 row_ror:1 row_mask:0xf bank_mask:0xf
    v_mul_f32 v12, s4, v12
    v_mul_f32 v13, s4, v13
    v_mul_f32 v14, s4, v14
    v_mul_f32 v15, s4, v15
    v_mul_f32 v16, s4, v16
    v_mul_f32 v17, s4, v17
    v_mul_f32 v18, s4, v18
    v_mul_f32 v19, s4, v19
    v_mul_f32 v20, s4, v20
    v_mul_f32 v21, s4, v21
    v_mul_f32 v22, s4, v22
    v_mul_f32 v23, s4, v23
    v_mul_f32 v24, s4, v24
    v_mul_f32 v25, s4, v25
    v_mul_f32 v26, s4, v26
    v_mul_f32 v27, s4, v27
    v_max3_f32 v40, v12, v13, v14
    v_max3_f32 v40, v40, v15, v16
    v_max3_f32 v40, v40, v17, v18
    v_max3_f32 v40, v40, v19, v20
    v_max3_f32 v40, v40, v21, v22
    v_max3_f32 v40, v40, v23, v24
    v_max3_f32 v40, v40, v25, v26
    v_max_f32 v40, v40, v27
    v_mov_b32 v41, v40
    s_nop 1
    v_permlane16_swap_b32 v40, v41
    s_nop 1
    v_max_f32 v40, v40, v41
    v_mov_b32 v41, v40
    s_nop 1
    v_permlane32_swap_b32 v40, v41
    s_nop 1
    v_max_f32 v40, v40, v41
    v_sub_f32 v12, v12, v40
    v_sub_f32 v13, v13, v40
    v_sub_f32 v14, v14, v40
    v_sub_f32 v15, v15, v40
    v_sub_f32 v16, v16, v40
    v_sub_f32 v17, v17, v40
    v_sub_f32 v18, v18, v40
    v_sub_f32 v19, v19, v40
    v_sub_f32 v20, v20, v40
    v_sub_f32 v21, v21, v40
    v_sub_f32 v22, v22, v40
    v_sub_f32 v23, v23, v40
    v_sub_f32 v24, v24, v40
    v_sub_f32 v25, v25, v40
    v_sub_f32 v26, v26, v40
    v_sub_f32 v27, v27, v40
    v_exp_f32 v12, v12
    v_exp_f32 v13, v13
    v_exp_f32 v14, v14
    v_exp_f32 v15, v15
    v_exp_f32 v16, v16
    v_exp_f32 v17, v17
    v_exp_f32 v18, v18
    v_exp_f32 v19, v19
    v_exp_f32 v20, v20
    v_exp_f32 v21, v21
    v_exp_f32 v22, v22
    v_exp_f32 v23, v23
    v_exp_f32 v24, v24
    v_exp_f32 v25, v25
    v_exp_f32 v26, v26
    v_exp_f32 v27, v27
    s_nop 0
    v_add_f32 v41, v12, v13
    v_add_f32 v41, v41, v14
    v_add_f32 v41, v41, v15
    v_add_f32 v41, v41, v16
    v_add_f32 v41, v41, v17
    v_add_f32 v41, v41, v18
    v_add_f32 v41, v41, v19
    v_add_f32 v41, v41, v20
    v_add_f32 v41, v41, v21
    v_add_f32 v41, v41, v22
    v_add_f32 v41, v41, v23
    v_add_f32 v41, v41, v24
    v_add_f32 v41, v41, v25
    v_add_f32 v41, v41, v26
    v_add_f32 v41, v41, v27
    v_mov_b32 v42, v41
    s_nop 1
    v_permlane16_swap_b32 v41, v42
    s_nop 1
    v_add_f32 v41, v41, v42
    v_mov_b32 v42, v41
    s_nop 1
    v_permlane32_swap_b32 v41, v42
    s_nop 1
    v_add_f32 v41, v41, v42
    s_lshl_b32 s6, s42, 3
    v_add_u32 v42, s6, v10
    ds_write_b64 v42, v[40:41]
    v_cvt_pk_bf16_f32 v12, v12, v12
    v_cvt_pk_bf16_f32 v13, v13, v13
    v_cvt_pk_bf16_f32 v14, v14, v14
    v_cvt_pk_bf16_f32 v15, v15, v15
    v_cvt_pk_bf16_f32 v16, v16, v16
    v_cvt_pk_bf16_f32 v17, v17, v17
    v_cvt_pk_bf16_f32 v18, v18, v18
    v_cvt_pk_bf16_f32 v19, v19, v19
    v_cvt_pk_bf16_f32 v20, v20, v20
    v_cvt_pk_bf16_f32 v21, v21, v21
    v_cvt_pk_bf16_f32 v22, v22, v22
    v_cvt_pk_bf16_f32 v23, v23, v23
    v_cvt_pk_bf16_f32 v24, v24, v24
    v_cvt_pk_bf16_f32 v25, v25, v25
    v_cvt_pk_bf16_f32 v26, v26, v26
    v_cvt_pk_bf16_f32 v27, v27, v27
    v_and_b32 v44, v12, v32
    v_and_b32 v45, v12, v33
    v_and_b32 v46, v12, v34
    v_and_b32 v47, v12, v35
    v_and_b32 v48, v13, v32
    v_and_b32 v49, v13, v33
    v_and_b32 v50, v13, v34
    v_and_b32 v51, v13, v35
    v_and_b32 v52, v14, v32
    v_and_b32 v53, v14, v33
    v_and_b32 v54, v14, v34
    v_and_b32 v55, v14, v35
    v_and_b32 v56, v15, v32
    v_and_b32 v57, v15, v33
    v_and_b32 v58, v15, v34
    v_and_b32 v59, v15, v35
    v_and_b32 v60, v16, v32
    v_and_b32 v61, v16, v33
    v_and_b32 v62, v16, v34
    v_and_b32 v63, v16, v35
    v_and_b32 v64, v17, v32
    v_and_b32 v65, v17, v33
    v_and_b32 v66, v17, v34
    v_and_b32 v67, v17, v35
    v_and_b32 v68, v18, v32
    v_and_b32 v69, v18, v33
    v_and_b32 v70, v18, v34
    v_and_b32 v71, v18, v35
    v_and_b32 v72, v19, v32
    v_and_b32 v73, v19, v33
    v_and_b32 v74, v19, v34
    v_and_b32 v75, v19, v35
    v_and_b32 v76, v20, v32
    v_and_b32 v77, v20, v33
    v_and_b32 v78, v20, v34
    v_and_b32 v79, v20, v35
    v_and_b32 v80, v21, v32
    v_and_b32 v81, v21, v33
    v_and_b32 v82, v21, v34
    v_and_b32 v83, v21, v35
    v_and_b32 v84, v22, v32
    v_and_b32 v85, v22, v33
    v_and_b32 v86, v22, v34
    v_and_b32 v87, v22, v35
    v_and_b32 v88, v23, v32
    v_and_b32 v89, v23, v33
    v_and_b32 v90, v23, v34
    v_and_b32 v91, v23, v35
    v_and_b32 v92, v24, v32
    v_and_b32 v93, v24, v33
    v_and_b32 v94, v24, v34
    v_and_b32 v95, v24, v35
    v_and_b32 v96, v25, v32
    v_and_b32 v97, v25, v33
    v_and_b32 v98, v25, v34
    v_and_b32 v99, v25, v35
    v_and_b32 v100, v26, v32
    v_and_b32 v101, v26, v33
    v_and_b32 v102, v26, v34
    v_and_b32 v103, v26, v35
    v_and_b32 v104, v27, v32
    v_and_b32 v105, v27, v33
    v_and_b32 v106, v27, v34
    v_and_b32 v107, v27, v35
    s_waitcnt lgkmcnt(0)
    s_mul_i32 s43, s43, 0x9E3779B1
    s_add_u32 s43, s43, 0x7F4A7C15
    v_mov_b32 v175, s43
    s_mov_b32 s57, s43
    s_cmp_ge_u32 s42, 4
    s_cbranch_scc1 L_early2
    s_barrier
    buffer_load_dwordx4 v[108:111], v1, s[20:23], s44 offen offset:0 nt
    buffer_load_dwordx4 v[112:115], v1, s[20:23], s44 offen offset:1024 nt
    buffer_load_dwordx4 v[116:119], v1, s[20:23], s44 offen offset:2048 nt
    buffer_load_dwordx4 v[120:123], v1, s[20:23], s44 offen offset:3072 nt
    buffer_load_dwordx4 v[124:127], v1, s[20:23], s45 offen offset:0 nt
    buffer_load_dwordx4 v[128:131], v1, s[20:23], s45 offen offset:1024 nt
    buffer_load_dwordx4 v[132:135], v1, s[20:23], s45 offen offset:2048 nt
    buffer_load_dwordx4 v[136:139], v1, s[20:23], s45 offen offset:3072 nt
    buffer_load_dwordx4 v[140:143], v1, s[20:23], s46 offen offset:0 nt
    buffer_load_dwordx4 v[144:147], v1, s[20:23], s46 offen offset:1024 nt
    buffer_load_dwordx4 v[148:151], v1, s[20:23], s46 offen offset:2048 nt
    buffer_load_dwordx4 v[152:155], v1, s[20:23], s46 offen offset:3072 nt
    buffer_load_dwordx4 v[156:159], v1, s[20:23], s47 offen offset:0 nt
    buffer_load_dwordx4 v[160:163], v1, s[20:23], s47 offen offset:1024 nt
    buffer_load_dwordx4 v[164:167], v1, s[20:23], s47 offen offset:2048 nt
    buffer_load_dwordx4 v[168:171], v1, s[20:23], s47 offen offset:3072 nt
    s_barrier
    ds_read_b128 v[204:207], v10 offset:0
    ds_read_b128 v[208:211], v10 offset:16
    ds_read_b128 v[212:215], v10 offset:32
    ds_read_b128 v[216:219], v10 offset:48
    s_waitcnt lgkmcnt(0)
    v_max3_f32 v220, v204, v206, v208
    v_max3_f32 v220, v220, v210, v212
    v_max3_f32 v220, v220, v214, v216
    v_max_f32 v220, v220, v218
    v_sub_f32 v204, v204, v220
    v_sub_f32 v206, v206, v220
    v_sub_f32 v208, v208, v220
    v_sub_f32 v210, v210, v220
    v_sub_f32 v212, v212, v220
    v_sub_f32 v214, v214, v220
    v_sub_f32 v216, v216, v220
    v_sub_f32 v218, v218, v220
    v_sub_f32 v11, v40, v220
    v_exp_f32 v204, v204
    v_exp_f32 v206, v206
    v_exp_f32 v208, v208
    v_exp_f32 v210, v210
    v_exp_f32 v212, v212
    v_exp_f32 v214, v214
    v_exp_f32 v216, v216
    v_exp_f32 v218, v218
    v_exp_f32 v11, v11
    v_mul_f32 v221, v204, v205
    v_fmac_f32 v221, v206, v207
    v_fmac_f32 v221, v208, v209
    v_fmac_f32 v221, v210, v211
    v_fmac_f32 v221, v212, v213
    v_fmac_f32 v221, v214, v215
    v_fmac_f32 v221, v216, v217
    v_fmac_f32 v221, v218, v219
    v_rcp_f32 v222, v221
    v_log_f32 v221, v221
    s_nop 0
    v_mul_f32 v11, v11, v222
    v_add_f32 v174, v220, v221
    s_waitcnt vmcnt(15)
    v_mfma_f32_16x16x32_bf16 v[36:39], v[44:47], v[108:111], 0
    s_waitcnt vmcnt(14)
    v_mfma_f32_16x16x32_bf16 v[36:39], v[48:51], v[112:115], v[36:39]
    s_waitcnt vmcnt(13)
    v_mfma_f32_16x16x32_bf16 v[36:39], v[52:55], v[116:119], v[36:39]
    s_waitcnt vmcnt(12)
    v_mfma_f32_16x16x32_bf16 v[36:39], v[56:59], v[120:123], v[36:39]
    s_waitcnt vmcnt(11)
    v_mfma_f32_16x16x32_bf16 v[36:39], v[60:63], v[124:127], v[36:39]
    s_waitcnt vmcnt(10)
    v_mfma_f32_16x16x32_bf16 v[36:39], v[64:67], v[128:131], v[36:39]
    s_waitcnt vmcnt(9)
    v_mfma_f32_16x16x32_bf16 v[36:39], v[68:71], v[132:135], v[36:39]
    s_waitcnt vmcnt(8)
    v_mfma_f32_16x16x32_bf16 v[36:39], v[72:75], v[136:139], v[36:39]
    s_waitcnt vmcnt(7)
    v_mfma_f32_16x16x32_bf16 v[36:39], v[76:79], v[140:143], v[36:39]
    s_waitcnt vmcnt(6)
    v_mfma_f32_16x16x32_bf16 v[36:39], v[80:83], v[144:147], v[36:39]
    s_waitcnt vmcnt(5)
    v_mfma_f32_16x16x32_bf16 v[36:39], v[84:87], v[148:151], v[36:39]
    s_waitcnt vmcnt(4)
    v_mfma_f32_16x16x32_bf16 v[36:39], v[88:91], v[152:155], v[36:39]
    s_waitcnt vmcnt(3)
    v_mfma_f32_16x16x32_bf16 v[36:39], v[92:95], v[156:159], v[36:39]
    s_waitcnt vmcnt(2)
    v_mfma_f32_16x16x32_bf16 v[36:39], v[96:99], v[160:163], v[36:39]
    s_waitcnt vmcnt(1)
    v_mfma_f32_16x16x32_bf16 v[36:39], v[100:103], v[164:167], v[36:39]
    s_waitcnt vmcnt(0)
    v_mfma_f32_16x16x32_bf16 v[36:39], v[104:107], v[168:171], v[36:39]
    s_nop 7
    s_branch L_fin
L_early2:
    s_waitcnt vmcnt(15)
    v_mfma_f32_16x16x32_bf16 v[36:39], v[44:47], v[108:111], 0
    s_waitcnt vmcnt(14)
    v_mfma_f32_16x16x32_bf16 v[36:39], v[48:51], v[112:115], v[36:39]
    s_waitcnt vmcnt(13)
    v_mfma_f32_16x16x32_bf16 v[36:39], v[52:55], v[116:119], v[36:39]
    s_waitcnt vmcnt(12)
    v_mfma_f32_16x16x32_bf16 v[36:39], v[56:59], v[120:123], v[36:39]
    s_waitcnt vmcnt(11)
    v_mfma_f32_16x16x32_bf16 v[36:39], v[60:63], v[124:127], v[36:39]
    s_waitcnt vmcnt(10)
    v_mfma_f32_16x16x32_bf16 v[36:39], v[64:67], v[128:131], v[36:39]
    s_waitcnt vmcnt(9)
    v_mfma_f32_16x16x32_bf16 v[36:39], v[68:71], v[132:135], v[36:39]
    s_waitcnt vmcnt(8)
    v_mfma_f32_16x16x32_bf16 v[36:39], v[72:75], v[136:139], v[36:39]
    s_waitcnt vmcnt(7)
    v_mfma_f32_16x16x32_bf16 v[36:39], v[76:79], v[140:143], v[36:39]
    s_waitcnt vmcnt(6)
    v_mfma_f32_16x16x32_bf16 v[36:39], v[80:83], v[144:147], v[36:39]
    s_waitcnt vmcnt(5)
    v_mfma_f32_16x16x32_bf16 v[36:39], v[84:87], v[148:151], v[36:39]
    s_waitcnt vmcnt(4)
    v_mfma_f32_16x16x32_bf16 v[36:39], v[88:91], v[152:155], v[36:39]
    s_waitcnt vmcnt(3)
    v_mfma_f32_16x16x32_bf16 v[36:39], v[92:95], v[156:159], v[36:39]
    s_waitcnt vmcnt(2)
    v_mfma_f32_16x16x32_bf16 v[36:39], v[96:99], v[160:163], v[36:39]
    s_waitcnt vmcnt(1)
    v_mfma_f32_16x16x32_bf16 v[36:39], v[100:103], v[164:167], v[36:39]
    s_waitcnt vmcnt(0)
    v_mfma_f32_16x16x32_bf16 v[36:39], v[104:107], v[168:171], v[36:39]
    s_load_dwordx2 s[58:59], s[28:29], s60
    s_waitcnt lgkmcnt(0)
    s_cmp_lg_u32 s42, 4
    s_cbranch_scc1 L_back
    s_mov_b64 vcc, 0
    s_mov_b64 exec, 0
    s_mov_b64 s[10:11], 0
    s_mov_b64 s[12:13], 0
    s_mov_b64 s[14:15], 0
    s_cmp_eq_u32 s41, 0
    s_cbranch_scc1 L_ctail
    s_branch L_ptail
L_back0:
    s_mov_b64 exec, -1
L_back:
    s_barrier
    ds_read_b128 v[204:207], v10 offset:0
    ds_read_b128 v[208:211], v10 offset:16
    ds_read_b128 v[212:215], v10 offset:32
    ds_read_b128 v[216:219], v10 offset:48
    s_waitcnt lgkmcnt(0)
    v_max3_f32 v220, v204, v206, v208
    v_max3_f32 v220, v220, v210, v212
    v_max3_f32 v220, v220, v214, v216
    v_max_f32 v220, v220, v218
    v_sub_f32 v204, v204, v220
    v_sub_f32 v206, v206, v220
    v_sub_f32 v208, v208, v220
    v_sub_f32 v210, v210, v220
    v_sub_f32 v212, v212, v220
    v_sub_f32 v214, v214, v220
    v_sub_f32 v216, v216, v220
    v_sub_f32 v218, v218, v220
    v_sub_f32 v11, v40, v220
    v_exp_f32 v204, v204
    v_exp_f32 v206, v206
    v_exp_f32 v208, v208
    v_exp_f32 v210, v210
    v_exp_f32 v212, v212
    v_exp_f32 v214, v214
    v_exp_f32 v216, v216
    v_exp_f32 v218, v218
    v_exp_f32 v11, v11
    v_mul_f32 v221, v204, v205
    v_fmac_f32 v221, v206, v207
    v_fmac_f32 v221, v208, v209
    v_fmac_f32 v221, v210, v211
    v_fmac_f32 v221, v212, v213
    v_fmac_f32 v221, v214, v215
    v_fmac_f32 v221, v216, v217
    v_fmac_f32 v221, v218, v219
    v_rcp_f32 v222, v221
    v_log_f32 v221, v221
    s_nop 0
    v_mul_f32 v11, v11, v222
    v_add_f32 v174, v220, v221
L_fin:
    v_pk_mul_f32 v[36:37], v[36:37], v[10:11] op_sel:[0,1] op_sel_hi:[1,1]
    v_pk_mul_f32 v[38:39], v[38:39], v[10:11] op_sel:[0,1] op_sel_hi:[1,1]
    s_mov_b32 exec_hi, 0
    ds_write_b128 v6, v[36:39]
    s_waitcnt lgkmcnt(0)
    s_barrier
    s_cmp_eq_u32 s41, 0
    s_cbranch_scc1 L_cons_entry
    s_cmp_lg_u32 s42, 4
    s_cbranch_scc1 L_end
    s_mov_b32 exec_hi, -1
L_ptail:
    ds_read_b64 v[204:205], v7 offset:0
    ds_read_b64 v[206:207], v7 offset:544
    ds_read_b64 v[208:209], v7 offset:1088
    ds_read_b64 v[210:211], v7 offset:1632
    ds_read_b64 v[212:213], v7 offset:2176
    ds_read_b64 v[214:215], v7 offset:2720
    ds_read_b64 v[216:217], v7 offset:3264
    ds_read_b64 v[218:219], v7 offset:3808
    s_waitcnt lgkmcnt(6)
    v_pk_add_f32 v[204:205], v[204:205], v[206:207]
    s_waitcnt lgkmcnt(4)
    v_pk_add_f32 v[208:209], v[208:209], v[210:211]
    s_waitcnt lgkmcnt(2)
    v_pk_add_f32 v[212:213], v[212:213], v[214:215]
    v_pk_add_f32 v[204:205], v[204:205], v[208:209]
    s_waitcnt lgkmcnt(0)
    v_pk_add_f32 v[216:217], v[216:217], v[218:219]
    v_pk_add_f32 v[204:205], v[204:205], v[212:213]
    v_pk_add_f32 v[172:173], v[204:205], v[216:217]
    s_cmp_eq_u64 s[56:57], s[58:59]
    s_cbranch_execz L_back0
    s_cbranch_scc0 L_pubB
    buffer_store_dwordx4 v[172:175], v227, s[28:31], s55 offen
    s_endpgm
L_pubB:
    buffer_store_dwordx4 v[172:175], v1, s[28:31], s50 offen sc0 sc1
L_nob:
    s_endpgm
L_cons_entry:
    s_mov_b64 s[12:13], -1
    s_mov_b32 s14, 0x01010101
    s_mov_b32 s15, 0x01010101
    s_mov_b32 s10, 0xfefefefe
    s_mov_b32 s11, 0xfefefefe
L_ctail:
    s_mov_b64 exec, s[10:11]
    s_cbranch_execz L_skip1
    buffer_load_dwordx4 v[176:179], v1, s[28:31], s53 offen sc1
L_skip1:
    s_mov_b64 exec, s[12:13]
    ds_read_b64 v[204:205], v225
    s_mov_b32 s8, 0
    s_mov_b32 s9, 0
    s_waitcnt lgkmcnt(0)
    s_nop 1
    v_add_f32_dpp v204, v204, v204 quad_perm:[1,0,3,2] row_mask:0xf bank_mask:0xf
    v_add_f32_dpp v205, v205, v205 quad_perm:[1,0,3,2] row_mask:0xf bank_mask:0xf
    s_nop 0
    v_add_f32_dpp v204, v204, v204 quad_perm:[2,3,0,1] row_mask:0xf bank_mask:0xf
    v_add_f32_dpp v205, v205, v205 quad_perm:[2,3,0,1] row_mask:0xf bank_mask:0xf
    s_nop 0
    v_add_f32_dpp v204, v204, v204 row_half_mirror row_mask:0xf bank_mask:0xf
    v_add_f32_dpp v205, v205, v205 row_half_mirror row_mask:0xf bank_mask:0xf
    s_mov_b64 exec, s[14:15]
    v_mov_b32 v176, v204
    v_mov_b32 v177, v205
    v_mov_b32 v178, v174
    s_mov_b64 exec, s[10:11]
    s_branch L_chk
L_pollB:
    buffer_load_dwordx4 v[176:179], v224, s[28:31], s48 offen sc1
    s_cmp_gt_u32 s9, 0x1000000
    s_cbranch_scc1 L_end
    s_branch L_chk
L_poll:
    s_mov_b64 exec, vcc
    s_add_u32 s9, s9, 1
    s_and_b32 s6, s9, 15
    s_cbranch_scc0 L_pollB
    buffer_load_dwordx4 v[176:179], v1, s[28:31], s53 offen sc1
L_chk:
    s_waitcnt vmcnt(0)
    v_cmp_ne_u32 vcc, s43, v179
    s_cbranch_vccnz L_poll
    s_mov_b64 exec, s[12:13]
    v_max_f32_dpp v220, v178, v178 quad_perm:[1,0,3,2] row_mask:0xf bank_mask:0xf
    s_nop 1
    v_max_f32_dpp v220, v220, v220 quad_perm:[2,3,0,1] row_mask:0xf bank_mask:0xf
    s_nop 1
    v_max_f32_dpp v220, v220, v220 row_half_mirror row_mask:0xf bank_mask:0xf
    v_sub_f32 v178, v178, v220
    v_exp_f32 v178, v178
    s_nop 0
    v_pk_mul_f32 v[176:177], v[176:177], v[178:179] op_sel_hi:[1,0]
    s_nop 1
    v_add_f32_dpp v178, v178, v178 quad_perm:[1,0,3,2] row_mask:0xf bank_mask:0xf
    v_add_f32_dpp v176, v176, v176 quad_perm:[1,0,3,2] row_mask:0xf bank_mask:0xf
    v_add_f32_dpp v177, v177, v177 quad_perm:[1,0,3,2] row_mask:0xf bank_mask:0xf
    v_add_f32_dpp v178, v178, v178 quad_perm:[2,3,0,1] row_mask:0xf bank_mask:0xf
    v_add_f32_dpp v176, v176, v176 quad_perm:[2,3,0,1] row_mask:0xf bank_mask:0xf
    v_add_f32_dpp v177, v177, v177 quad_perm:[2,3,0,1] row_mask:0xf bank_mask:0xf
    v_add_f32_dpp v178, v178, v178 row_half_mirror row_mask:0xf bank_mask:0xf
    v_add_f32_dpp v176, v176, v176 row_half_mirror row_mask:0xf bank_mask:0xf
    v_add_f32_dpp v177, v177, v177 row_half_mirror row_mask:0xf bank_mask:0xf
    v_rcp_f32 v178, v178
    s_mov_b64 exec, s[14:15]
    v_pk_mul_f32 v[176:177], v[176:177], v[178:179] op_sel_hi:[1,0]
    v_cvt_pk_bf16_f32 v176, v176, v177
    s_cbranch_execz L_back0
    buffer_store_dword v176, v226, s[36:39], s54 offen
    s_cmp_lg_u32 s42, 0
    s_cbranch_scc1 L_noep
    buffer_store_dword v175, v8, s[28:31], s5 offen
L_noep:
L_end:
    s_endpgm
L_codeend:
.section .rodata,"a"
.p2align 6
.amdhsa_kernel standalone__softmax_full_bidir__decode_kernel
  .amdhsa_next_free_vgpr 228
  .amdhsa_next_free_sgpr 62
  .amdhsa_accum_offset 228
  .amdhsa_group_segment_fixed_size 0
  .amdhsa_kernarg_size 48
  .amdhsa_user_sgpr_count 2
  .amdhsa_user_sgpr_kernarg_segment_ptr 1
  .amdhsa_system_sgpr_workgroup_id_x 1
.end_amdhsa_kernel
```
